```python
import torch

def _softmax(x, axis=-1):
    return torch.softmax(x, dim=axis)
def _gelu(x):
    return torch.nn.functional.gelu(x, approximate="tanh")
def _silu(x):
    return torch.nn.functional.silu(x)
def _sigmoid(x):
    return torch.sigmoid(x)
def _layernorm(x, axis=-1, eps=1e-5):
    m = x.mean(dim=axis, keepdim=True)
    v = x.var(dim=axis, keepdim=True, unbiased=False)
    return (x - m) / torch.sqrt(v + eps)
def _scatter_add(tgt, idx, src, axis=0):
    return tgt.clone().index_add_(axis, idx, src)
def _segment_sum(src, seg, n):
    out = torch.zeros((n,) + src.shape[1:], dtype=src.dtype)
    return out.index_add_(0, seg, src)
def _pad(x, pw):
    flat = tuple(v for pair in reversed(pw) for v in pair)
    return torch.nn.functional.pad(x, flat)

kernel_name = 'gather_scatter__kernel_systems_refs_featgraph__graph'

def setup_inputs():

    _w = (lambda a: (lambda t: t.to(torch.bfloat16) if t.is_floating_point() else t)(torch.as_tensor(a)))
    N, deg, D = 50000, 16, 64
    E = N * deg
    scale = D ** -0.5
    src = (lambda lo, hi, *s: torch.randint(lo, hi, s))(0, N, E).to(torch.int64)
    dst = (lambda lo, hi, *s: torch.randint(lo, hi, s))(0, N, E).to(torch.int64)
    return {
        "x": _w((lambda *s: torch.randn(*s, dtype=torch.bfloat16) * 0.8)(N, D)),
        "src": _w(src),
        "dst": _w(dst),
        "w_q": _w((lambda *s: torch.randn(*s, dtype=torch.bfloat16) * 0.8)(D, D) * scale),
        "w_v": _w((lambda *s: torch.randn(*s, dtype=torch.bfloat16) * 0.05)(D, D) * scale),
    }

def reference(x, src, dst, w_q, w_v):
    N, D = x.shape
    xs = x[src]
    xd = x[dst]
    q = xd @ w_q
    logits = torch.einsum('ed,ed->e', xs, q) * (float(D) ** -0.5)
    alpha = _sigmoid(logits)
    msg = alpha[:, None] * (xs @ w_v)
    return _segment_sum(msg, dst, N)
```

```asm
; @launch grid=(241,1,1) block=(1024,1,1) lds=163840
.amdgcn_target "amdgcn-amd-amdhsa--gfx950"
.text
.globl gather_scatter__kernel_systems_refs_featgraph__graph_kernel
.p2align 8
.type gather_scatter__kernel_systems_refs_featgraph__graph_kernel,@function
gather_scatter__kernel_systems_refs_featgraph__graph_kernel:
s_cmp_ge_u32 s2, 241
s_cbranch_scc1 G_end
s_load_dwordx16 s[4:19], s[0:1], 0
v_lshrrev_b32 v2, 6, v0
v_and_b32 v1, 63, v0
v_readfirstlane_b32 s68, v2
s_mov_b32 s73, 8388480
s_movk_i32 s74, 0x78
s_mov_b32 s75, 0xbe38aa3b
s_mov_b32 s79, 0x80000000
s_movk_i32 s80, 0x1fc
s_mov_b32 s72, 0
v_lshlrev_b32 v2, 4, v1
v_lshlrev_b32 v3, 4, v0
s_mul_i32 s83, s2, 13344
s_sub_u32 s76, 3200000, s83
s_max_i32 s76, s76, 0
s_min_u32 s76, s76, 13344
v_cmp_gt_u32 s[52:53], s76, v3
v_mov_b32 v84, 0
v_mov_b32 v85, 0
v_mov_b32 v86, 0
v_mov_b32 v87, 0
s_waitcnt lgkmcnt(0)
s_mov_b32 s28, s6
s_mov_b32 s29, s7
s_mov_b32 s30, 3200000
s_mov_b32 s31, 0x00020000
s_mov_b32 s36, s8
s_mov_b32 s37, s9
s_mov_b32 s38, 3200000
s_mov_b32 s39, 0x00020000
s_mov_b64 exec, s[52:53]
s_cbranch_execz P_noload
buffer_load_dwordx4 v[40:43], v3, s[36:39], s83 offen
buffer_load_dwordx4 v[44:47], v3, s[28:31], s83 offen
P_noload:
s_mov_b64 exec, -1
s_add_u32 s44, s18, 8192000
s_addc_u32 s45, s19, 0
s_mov_b32 s46, 8192
s_mov_b32 s47, 0x00020000
s_lshl_b32 s3, s2, 4
s_add_u32 s3, s3, s68
s_cmp_lg_u32 s3, 3841
s_cbranch_scc1 P_nors
s_movk_i32 s76, 0
buffer_store_dwordx4 v[84:87], v2, s[44:47], s76 offen sc1
s_movk_i32 s76, 1024
buffer_store_dwordx4 v[84:87], v2, s[44:47], s76 offen sc1
s_movk_i32 s76, 2048
buffer_store_dwordx4 v[84:87], v2, s[44:47], s76 offen sc1
s_movk_i32 s76, 3072
buffer_store_dwordx4 v[84:87], v2, s[44:47], s76 offen sc1
s_movk_i32 s76, 4096
buffer_store_dwordx4 v[84:87], v2, s[44:47], s76 offen sc1
s_movk_i32 s76, 5120
buffer_store_dwordx4 v[84:87], v2, s[44:47], s76 offen sc1
s_movk_i32 s76, 6144
buffer_store_dwordx4 v[84:87], v2, s[44:47], s76 offen sc1
s_movk_i32 s76, 7168
buffer_store_dwordx4 v[84:87], v2, s[44:47], s76 offen sc1
P_nors:
ds_write_b128 v3, v[84:87] offset:32768
ds_write_b128 v3, v[84:87] offset:49152
v_lshlrev_b32 v97, 3, v1
v_and_b32 v94, 15, v1
v_lshrrev_b32 v95, 4, v1
s_cmp_eq_u32 s68, 0
s_cbranch_scc0 G_i1
v_add_u32 v98, 154112, v97
ds_write_b64 v98, v[84:85]
v_add_u32 v98, 65536, v2
ds_write_b128 v98, v[84:87]
v_mov_b32 v98, 66560
v_mov_b32 v88, -1
v_mov_b32 v89, -1
ds_write_b64 v98, v[88:89]
G_i1:
v_lshlrev_b32 v98, 2, v95
v_sub_u32 v98, v94, v98
v_mov_b32 v86, 0x3f80
v_mov_b32 v87, 0x3f800000
v_cmp_eq_u32 vcc, 0, v98
v_cmp_eq_u32 s[50:51], 1, v98
v_mov_b32 v28, 4026593280
v_mov_b32 v99, 4026531840
v_cndmask_b32 v84, 0, v86, vcc
v_cndmask_b32 v84, v84, v87, s[50:51]
v_cndmask_b32 v28, v28, v99, vcc
v_mov_b32 v99, 61440
v_cndmask_b32 v28, v28, v99, s[50:51]
v_cmp_eq_u32 vcc, 2, v98
v_cmp_eq_u32 s[50:51], 3, v98
v_mov_b32 v29, 4026593280
v_mov_b32 v99, 4026531840
v_cndmask_b32 v85, 0, v86, vcc
v_cndmask_b32 v85, v85, v87, s[50:51]
v_cndmask_b32 v29, v29, v99, vcc
v_mov_b32 v99, 61440
v_cndmask_b32 v29, v29, v99, s[50:51]
s_cmp_eq_u32 s68, 1
s_cbranch_scc0 G_i2
v_add_u32 v98, 155136, v97
ds_write_b64 v98, v[84:85]
G_i2:
s_mov_b32 s20, s4
s_mov_b32 s21, s5
s_mov_b32 s22, 6400000
s_mov_b32 s23, 0x00020000
s_mov_b32 s24, s18
s_mov_b32 s25, s19
s_mov_b32 s26, 7403520
s_mov_b32 s27, 0x00020000
s_add_u32 s40, s18, 8454144
s_addc_u32 s41, s19, 0
s_mov_b32 s42, 3202560
s_mov_b32 s43, 0x00020000
s_mov_b32 s32, s14
s_mov_b32 s33, s15
s_mov_b32 s34, 6400000
s_mov_b32 s35, 0x00020000
s_waitcnt lgkmcnt(0)
s_barrier
s_mov_b32 s28, s16
s_mov_b32 s29, s17
s_mov_b32 s30, 256
s_mov_b32 s31, 0x00020000
s_lshl_b32 s87, s2, 2
s_cmp_lg_u32 s3, 3841
s_cbranch_scc1 P_nopub
v_mov_b32 v104, 1
v_mov_b32 v105, 0
s_mov_b64 exec, 1
s_waitcnt vmcnt(0)
buffer_store_dword v104, v105, s[28:31], 0 offen sc1
s_mov_b64 exec, -1
P_nopub:
s_cmp_ge_u32 s68, 8
s_cselect_b32 s36, s12, s10
s_cselect_b32 s37, s13, s11
s_mov_b32 s38, 8192
s_mov_b32 s39, 0x00020000
s_cselect_b32 s76, 155648, 0
s_and_b32 s77, s68, 7
s_lshl_b32 s77, s77, 10
s_add_u32 m0, s76, s77
v_lshlrev_b32 v97, 4, v1
buffer_load_dwordx4 v97, s[36:39], s77 offen lds
s_lshl_b32 s81, s2, 4
s_add_u32 s81, s81, s68
s_mul_i32 s81, s81, 1664
v_mov_b32 v2, 1
v_mov_b32 v99, 65536
s_mov_b64 exec, s[52:53]
s_cbranch_execz P_copy
s_waitcnt vmcnt(1)
v_mul_u32_u24 v52, 40330, v40
v_lshrrev_b32 v52, 19, v52
v_mad_i32_i24 v96, v52, -13, v40
v_lshl_or_b32 v48, v44, 7, s79
v_lshl_or_b32 v48, v96, 3, v48
v_lshrrev_b32 v96, 13, v44
v_and_b32 v97, 15, v52
v_lshl_or_b32 v96, v97, 3, v96
v_lshl_or_b32 v48, v96, 24, v48
v_lshrrev_b32 v52, 4, v52
v_lshl_add_u32 v96, v52, 2, v99
ds_add_rtn_u32 v56, v96, v2
v_mul_u32_u24 v53, 40330, v41
v_lshrrev_b32 v53, 19, v53
v_mad_i32_i24 v96, v53, -13, v41
v_lshl_or_b32 v49, v45, 7, s79
v_lshl_or_b32 v49, v96, 3, v49
v_lshrrev_b32 v96, 13, v45
v_and_b32 v97, 15, v53
v_lshl_or_b32 v96, v97, 3, v96
v_lshl_or_b32 v49, v96, 24, v49
v_lshrrev_b32 v53, 4, v53
v_lshl_add_u32 v96, v53, 2, v99
ds_add_rtn_u32 v57, v96, v2
v_mul_u32_u24 v54, 40330, v42
v_lshrrev_b32 v54, 19, v54
v_mad_i32_i24 v96, v54, -13, v42
v_lshl_or_b32 v50, v46, 7, s79
v_lshl_or_b32 v50, v96, 3, v50
v_lshrrev_b32 v96, 13, v46
v_and_b32 v97, 15, v54
v_lshl_or_b32 v96, v97, 3, v96
v_lshl_or_b32 v50, v96, 24, v50
v_lshrrev_b32 v54, 4, v54
v_lshl_add_u32 v96, v54, 2, v99
ds_add_rtn_u32 v58, v96, v2
v_mul_u32_u24 v55, 40330, v43
v_lshrrev_b32 v55, 19, v55
v_mad_i32_i24 v96, v55, -13, v43
v_lshl_or_b32 v51, v47, 7, s79
v_lshl_or_b32 v51, v96, 3, v51
v_lshrrev_b32 v96, 13, v47
v_and_b32 v97, 15, v55
v_lshl_or_b32 v96, v97, 3, v96
v_lshl_or_b32 v51, v96, 24, v51
v_lshrrev_b32 v55, 4, v55
v_lshl_add_u32 v96, v55, 2, v99
ds_add_rtn_u32 v59, v96, v2
s_waitcnt lgkmcnt(3)
v_add_u32 v96, v56, v52
v_and_b32 v96, 31, v96
v_lshlrev_b32 v96, 2, v96
v_lshl_or_b32 v96, v52, 7, v96
v_cmp_gt_u32 vcc, 32, v56
s_and_saveexec_b64 s[50:51], vcc
ds_write_b32 v96, v48 offset:32768
s_mov_b64 exec, s[50:51]
s_waitcnt lgkmcnt(2)
v_add_u32 v96, v57, v53
v_and_b32 v96, 31, v96
v_lshlrev_b32 v96, 2, v96
v_lshl_or_b32 v96, v53, 7, v96
v_cmp_gt_u32 vcc, 32, v57
s_and_saveexec_b64 s[50:51], vcc
ds_write_b32 v96, v49 offset:32768
s_mov_b64 exec, s[50:51]
s_waitcnt lgkmcnt(1)
v_add_u32 v96, v58, v54
v_and_b32 v96, 31, v96
v_lshlrev_b32 v96, 2, v96
v_lshl_or_b32 v96, v54, 7, v96
v_cmp_gt_u32 vcc, 32, v58
s_and_saveexec_b64 s[50:51], vcc
ds_write_b32 v96, v50 offset:32768
s_mov_b64 exec, s[50:51]
s_waitcnt lgkmcnt(0)
v_add_u32 v96, v59, v55
v_and_b32 v96, 31, v96
v_lshlrev_b32 v96, 2, v96
v_lshl_or_b32 v96, v55, 7, v96
v_cmp_gt_u32 vcc, 32, v59
s_and_saveexec_b64 s[50:51], vcc
ds_write_b32 v96, v51 offset:32768
s_mov_b64 exec, s[50:51]
v_max3_u32 v96, v56, v57, v58
v_max_u32 v96, v96, v59
v_cmp_lt_u32 vcc, 31, v96
s_cbranch_vccz P_copy
v_cmp_lt_u32 vcc, 31, v56
s_and_saveexec_b64 s[50:51], vcc
s_cbranch_execz P_ov0
ds_add_rtn_u32 v96, v99, v2 offset:1020
v_lshl_or_b32 v97, v40, 16, v44
s_waitcnt lgkmcnt(0)
v_lshlrev_b32 v96, 2, v96
v_cmp_gt_u32 vcc, 8, v96
v_add_u32 v98, v99, v96
s_and_saveexec_b64 s[48:49], vcc
ds_write_b32 v98, v97 offset:1024
s_andn2_b64 exec, s[48:49], exec
s_cbranch_execz P_ov0
v_subrev_u32 v96, 8, v96
buffer_store_dword v97, v96, s[40:43], s83 offen sc1
s_waitcnt vmcnt(0)
P_ov0:
s_mov_b64 exec, s[50:51]
v_cmp_lt_u32 vcc, 31, v57
s_and_saveexec_b64 s[50:51], vcc
s_cbranch_execz P_ov1
ds_add_rtn_u32 v96, v99, v2 offset:1020
v_lshl_or_b32 v97, v41, 16, v45
s_waitcnt lgkmcnt(0)
v_lshlrev_b32 v96, 2, v96
v_cmp_gt_u32 vcc, 8, v96
v_add_u32 v98, v99, v96
s_and_saveexec_b64 s[48:49], vcc
ds_write_b32 v98, v97 offset:1024
s_andn2_b64 exec, s[48:49], exec
s_cbranch_execz P_ov1
v_subrev_u32 v96, 8, v96
buffer_store_dword v97, v96, s[40:43], s83 offen sc1
s_waitcnt vmcnt(0)
P_ov1:
s_mov_b64 exec, s[50:51]
v_cmp_lt_u32 vcc, 31, v58
s_and_saveexec_b64 s[50:51], vcc
s_cbranch_execz P_ov2
ds_add_rtn_u32 v96, v99, v2 offset:1020
v_lshl_or_b32 v97, v42, 16, v46
s_waitcnt lgkmcnt(0)
v_lshlrev_b32 v96, 2, v96
v_cmp_gt_u32 vcc, 8, v96
v_add_u32 v98, v99, v96
s_and_saveexec_b64 s[48:49], vcc
ds_write_b32 v98, v97 offset:1024
s_andn2_b64 exec, s[48:49], exec
s_cbranch_execz P_ov2
v_subrev_u32 v96, 8, v96
buffer_store_dword v97, v96, s[40:43], s83 offen sc1
s_waitcnt vmcnt(0)
P_ov2:
s_mov_b64 exec, s[50:51]
v_cmp_lt_u32 vcc, 31, v59
s_and_saveexec_b64 s[50:51], vcc
s_cbranch_execz P_ov3
ds_add_rtn_u32 v96, v99, v2 offset:1020
v_lshl_or_b32 v97, v43, 16, v47
s_waitcnt lgkmcnt(0)
v_lshlrev_b32 v96, 2, v96
v_cmp_gt_u32 vcc, 8, v96
v_add_u32 v98, v99, v96
s_and_saveexec_b64 s[48:49], vcc
ds_write_b32 v98, v97 offset:1024
s_andn2_b64 exec, s[48:49], exec
s_cbranch_execz P_ov3
v_subrev_u32 v96, 8, v96
buffer_store_dword v97, v96, s[40:43], s83 offen sc1
s_waitcnt vmcnt(0)
P_ov3:
s_mov_b64 exec, s[50:51]
P_copy:
s_mov_b64 exec, -1
v_lshrrev_b32 v96, 3, v0
v_mul_u32_u24 v96, 30720, v96
v_and_b32 v97, 7, v0
v_lshl_add_u32 v96, v97, 4, v96
s_lshl_b32 s76, s2, 7
s_add_u32 s77, s76, 3932160
s_waitcnt lgkmcnt(0)
s_barrier
s_cmp_ge_u32 s2, 240
s_cbranch_scc1 P_nost
ds_read_b128 v[40:43], v3 offset:32768
ds_read_b128 v[44:47], v3 offset:49152
ds_read_b32 v48, v99 offset:1020
ds_read_b64 v[50:51], v99 offset:1024
s_waitcnt lgkmcnt(3)
buffer_store_dwordx4 v[40:43], v96, s[24:27], s76 offen sc1
s_waitcnt lgkmcnt(2)
buffer_store_dwordx4 v[44:47], v96, s[24:27], s77 offen sc1
v_cmp_eq_u32 vcc, 0, v0
s_and_saveexec_b64 s[50:51], vcc
s_cbranch_execz P_st2
s_add_u32 s36, s18, 8323072
s_addc_u32 s37, s19, 0
s_mov_b32 s38, 131072
s_mov_b32 s39, 0x00020000
s_lshl_b32 s76, s2, 3
s_lshl_b32 s77, s2, 2
s_add_u32 s77, s77, 65536
v_mov_b32 v49, 0
s_waitcnt lgkmcnt(0)
v_max_u32 v48, 2, v48
v_subrev_u32 v48, 2, v48
buffer_store_dwordx2 v[50:51], v49, s[36:39], s76 offen sc1
buffer_store_dword v48, v49, s[36:39], s77 offen sc1
P_st2:
s_mov_b64 exec, -1
s_cmp_lg_u32 s68, 0
s_cbranch_scc1 P_nord
v_mov_b32 v111, 0
buffer_load_dword v110, v111, s[28:31], 0 offen sc1
P_nord:
P_nost:
s_lshl_b32 s78, s68, 13
v_lshlrev_b32 v37, 7, v95
v_add_u32 v37, 155136, v37
v_and_b32 v98, 7, v1
v_lshlrev_b32 v99, 1, v95
v_xor_b32 v36, v98, v99
v_lshlrev_b32 v36, 4, v36
v_and_b32 v98, 6, v94
v_xor_b32 v98, v98, v95
v_lshlrev_b32 v98, 4, v98
v_lshl_add_u32 v34, v94, 7, v98
v_add_u32 v34, s78, v34
v_xor_b32 v35, 64, v34
v_lshrrev_b32 v98, 2, v1
v_lshlrev_b32 v98, 7, v98
v_and_b32 v99, 3, v1
v_lshl_add_u32 v98, v99, 3, v98
v_bfe_u32 v99, v1, 3, 2
v_lshl_add_u32 v30, v99, 5, v98
v_add_u32 v30, s78, v30
v_xor_b32 v31, 32, v30
v_xor_b32 v32, 64, v30
v_xor_b32 v33, 96, v30
s_waitcnt vmcnt(0)
s_barrier
s_mov_b32 s3, 0x40000
s_cmp_lg_u32 s68, 0
s_cbranch_scc1 P_wx
s_cmp_ge_u32 s2, 240
s_cbranch_scc1 P_wx
s_mov_b64 exec, 1
v_mov_b32 v98, 0
v_cmp_eq_u32 vcc, 1, v110
s_cbranch_vccnz P_arr
P_rpoll:
s_sleep 8
buffer_load_dword v99, v98, s[28:31], 0 offen sc1
s_sub_u32 s3, s3, 1
s_cbranch_scc1 P_arr
s_waitcnt vmcnt(0)
v_cmp_eq_u32 vcc, 1, v99
s_cbranch_vccz P_rpoll
P_arr:
s_mov_b64 exec, 0xff
v_lshlrev_b32 v98, 10, v1
buffer_store_dword v2, v98, s[44:47], s87 offen sc1
s_mov_b64 exec, -1
P_wx:
v_lshlrev_b32 v96, 7, v94
v_lshl_add_u32 v96, v95, 4, v96
v_mov_b32 v72, 0
v_mov_b32 v73, 0
v_mov_b32 v74, 0
v_mov_b32 v75, 0
v_mov_b32 v76, 0
v_mov_b32 v77, 0
v_mov_b32 v78, 0
v_mov_b32 v79, 0
v_cmp_gt_u32 vcc, 13, v94
s_mov_b64 exec, vcc
buffer_load_dwordx4 v[72:75], v96, s[20:23], s81 offen
buffer_load_dwordx4 v[76:79], v96, s[20:23], s81 offen offset:64
s_mov_b64 exec, -1
s_waitcnt vmcnt(0)
v_lshrrev_b32 v109, 4, v1
v_bfe_u32 v110, v1, 2, 2
v_lshl_add_u32 v110, v109, 3, v110
v_lshlrev_b32 v110, 7, v110
v_and_b32 v111, 3, v1
v_lshl_add_u32 v110, v111, 4, v110
ds_read_b64_tr_b16 v[56:57], v110 offset:0
ds_read_b64_tr_b16 v[58:59], v110 offset:512
ds_read_b64_tr_b16 v[60:61], v110 offset:4096
ds_read_b64_tr_b16 v[62:63], v110 offset:4608
ds_read_b64_tr_b16 v[64:65], v110 offset:8
ds_read_b64_tr_b16 v[66:67], v110 offset:520
ds_read_b64_tr_b16 v[68:69], v110 offset:4104
ds_read_b64_tr_b16 v[70:71], v110 offset:4616
ds_read_b64_tr_b16 v[84:85], v110 offset:64
ds_read_b64_tr_b16 v[86:87], v110 offset:576
ds_read_b64_tr_b16 v[88:89], v110 offset:4160
ds_read_b64_tr_b16 v[90:91], v110 offset:4672
ds_read_b64_tr_b16 v[100:101], v110 offset:72
ds_read_b64_tr_b16 v[102:103], v110 offset:584
ds_read_b64_tr_b16 v[104:105], v110 offset:4168
ds_read_b64_tr_b16 v[106:107], v110 offset:4680
s_waitcnt lgkmcnt(12)
v_mfma_f32_16x16x32_bf16 v[4:7], v[56:59], v[72:75], 0
v_mfma_f32_16x16x32_bf16 v[4:7], v[60:63], v[76:79], v[4:7]
s_waitcnt lgkmcnt(8)
v_mfma_f32_16x16x32_bf16 v[8:11], v[64:67], v[72:75], 0
v_mfma_f32_16x16x32_bf16 v[8:11], v[68:71], v[76:79], v[8:11]
s_waitcnt lgkmcnt(4)
v_mfma_f32_16x16x32_bf16 v[12:15], v[84:87], v[72:75], 0
v_mfma_f32_16x16x32_bf16 v[12:15], v[88:91], v[76:79], v[12:15]
s_waitcnt lgkmcnt(0)
v_mfma_f32_16x16x32_bf16 v[16:19], v[100:103], v[72:75], 0
v_mfma_f32_16x16x32_bf16 v[16:19], v[104:107], v[76:79], v[16:19]
s_nop 7
v_cvt_pk_bf16_f32 v20, v4, v5
v_cvt_pk_bf16_f32 v21, v6, v7
v_cvt_pk_bf16_f32 v22, v8, v9
v_cvt_pk_bf16_f32 v23, v10, v11
v_cvt_pk_bf16_f32 v24, v12, v13
v_cvt_pk_bf16_f32 v25, v14, v15
v_cvt_pk_bf16_f32 v26, v16, v17
v_cvt_pk_bf16_f32 v27, v18, v19
v_mov_b32 v4, 0
v_mov_b32 v5, 0
v_mov_b32 v6, 0
v_mov_b32 v7, 0
v_mov_b32 v8, 0
v_mov_b32 v9, 0
v_mov_b32 v10, 0
v_mov_b32 v11, 0
v_mov_b32 v12, 0
v_mov_b32 v13, 0
v_mov_b32 v14, 0
v_mov_b32 v15, 0
v_mov_b32 v16, 0
v_mov_b32 v17, 0
v_mov_b32 v18, 0
v_mov_b32 v19, 0
s_mov_b32 s77, 0x40000
s_cmp_lg_u32 s68, 0
s_cbranch_scc1 P_nopoll
v_lshlrev_b32 v98, 4, v1
s_lshr_b32 s76, s2, 0
s_and_b32 s76, s76, 7
s_lshl_b32 s76, s76, 10
v_cmp_le_u32 s[48:49], 60, v1
P_poll:
buffer_load_dwordx4 v[40:43], v98, s[44:47], s76 offen sc1
s_sub_u32 s77, s77, 1
s_cbranch_scc1 P_pdone
s_waitcnt vmcnt(0)
v_and_b32 v40, v40, v41
v_and_b32 v42, v42, v43
v_and_b32 v40, v40, v42
v_cmp_eq_u32 vcc, 1, v40
s_or_b64 vcc, vcc, s[48:49]
s_cmp_eq_u64 vcc, -1
s_cbranch_scc1 P_pdone
s_sleep 12
s_branch P_poll
P_pdone:
s_mov_b64 exec, -1
P_nopoll:
s_add_u32 s36, s18, 8323072
s_addc_u32 s37, s19, 0
s_mov_b32 s38, 131072
s_mov_b32 s39, 0x00020000
s_mul_i32 s76, s2, 30720
s_add_u32 s77, s76, 16384
s_waitcnt vmcnt(0)
s_barrier
buffer_load_dwordx4 v[40:43], v3, s[24:27], s76 offen sc1
s_cmp_ge_u32 s68, 14
s_cbranch_scc1 G_xo
buffer_load_dwordx4 v[44:47], v3, s[24:27], s77 offen sc1
s_branch G_q
G_xo:
v_subrev_u32 v94, 14336, v3
buffer_load_dwordx4 v[48:51], v94, s[36:39], 0 offen sc1
G_q:
v_mov_b32 v3, 154112
s_cmp_lt_u32 s68, 14
s_waitcnt vmcnt(0)
s_cbranch_scc1 G_batch
s_movk_i32 s77, 480
v_lshrrev_b32 v94, 2, v94
v_lshrrev_b32 v95, 16, v48
v_and_b32 v96, 0xffff, v48
v_mul_u32_u24 v97, 40330, v95
v_lshrrev_b32 v97, 19, v97
v_mad_i32_i24 v98, v97, -13, v95
v_lshl_or_b32 v44, v96, 7, s79
v_lshl_or_b32 v44, v98, 3, v44
v_lshrrev_b32 v98, 13, v96
v_and_b32 v99, 15, v97
v_lshl_or_b32 v98, v99, 3, v98
v_lshl_or_b32 v44, v98, 24, v44
v_lshrrev_b32 v97, 4, v97
v_cmp_eq_u32 vcc, s2, v97
v_add_u32 v98, 0, v94
v_cmp_gt_u32 s[84:85], s77, v98
s_and_b64 vcc, vcc, s[84:85]
s_nop 1
v_cndmask_b32 v44, 0, v44, vcc
v_lshrrev_b32 v95, 16, v49
v_and_b32 v96, 0xffff, v49
v_mul_u32_u24 v97, 40330, v95
v_lshrrev_b32 v97, 19, v97
v_mad_i32_i24 v98, v97, -13, v95
v_lshl_or_b32 v45, v96, 7, s79
v_lshl_or_b32 v45, v98, 3, v45
v_lshrrev_b32 v98, 13, v96
v_and_b32 v99, 15, v97
v_lshl_or_b32 v98, v99, 3, v98
v_lshl_or_b32 v45, v98, 24, v45
v_lshrrev_b32 v97, 4, v97
v_cmp_eq_u32 vcc, s2, v97
v_add_u32 v98, 1, v94
v_cmp_gt_u32 s[84:85], s77, v98
s_and_b64 vcc, vcc, s[84:85]
s_nop 1
v_cndmask_b32 v45, 0, v45, vcc
v_lshrrev_b32 v95, 16, v50
v_and_b32 v96, 0xffff, v50
v_mul_u32_u24 v97, 40330, v95
v_lshrrev_b32 v97, 19, v97
v_mad_i32_i24 v98, v97, -13, v95
v_lshl_or_b32 v46, v96, 7, s79
v_lshl_or_b32 v46, v98, 3, v46
v_lshrrev_b32 v98, 13, v96
v_and_b32 v99, 15, v97
v_lshl_or_b32 v98, v99, 3, v98
v_lshl_or_b32 v46, v98, 24, v46
v_lshrrev_b32 v97, 4, v97
v_cmp_eq_u32 vcc, s2, v97
v_add_u32 v98, 2, v94
v_cmp_gt_u32 s[84:85], s77, v98
s_and_b64 vcc, vcc, s[84:85]
s_nop 1
v_cndmask_b32 v46, 0, v46, vcc
v_lshrrev_b32 v95, 16, v51
v_and_b32 v96, 0xffff, v51
v_mul_u32_u24 v97, 40330, v95
v_lshrrev_b32 v97, 19, v97
v_mad_i32_i24 v98, v97, -13, v95
v_lshl_or_b32 v47, v96, 7, s79
v_lshl_or_b32 v47, v98, 3, v47
v_lshrrev_b32 v98, 13, v96
v_and_b32 v99, 15, v97
v_lshl_or_b32 v98, v99, 3, v98
v_lshl_or_b32 v47, v98, 24, v47
v_lshrrev_b32 v97, 4, v97
v_cmp_eq_u32 vcc, s2, v97
v_add_u32 v98, 3, v94
v_cmp_gt_u32 s[84:85], s77, v98
s_and_b64 vcc, vcc, s[84:85]
s_nop 1
v_cndmask_b32 v47, 0, v47, vcc
G_batch:
v_cmp_gt_i32 s[52:53], 0, v40
v_lshrrev_b32 v56, 22, v40
v_and_or_b32 v56, v56, s80, v3
v_cmp_gt_i32 s[54:55], 0, v41
v_lshrrev_b32 v57, 22, v41
v_and_or_b32 v57, v57, s80, v3
v_cmp_gt_i32 s[56:57], 0, v42
v_lshrrev_b32 v58, 22, v42
v_and_or_b32 v58, v58, s80, v3
v_cmp_gt_i32 s[58:59], 0, v43
v_lshrrev_b32 v59, 22, v43
v_and_or_b32 v59, v59, s80, v3
v_cmp_gt_i32 s[60:61], 0, v44
v_lshrrev_b32 v60, 22, v44
v_and_or_b32 v60, v60, s80, v3
v_cmp_gt_i32 s[62:63], 0, v45
v_lshrrev_b32 v61, 22, v45
v_and_or_b32 v61, v61, s80, v3
v_cmp_gt_i32 s[64:65], 0, v46
v_lshrrev_b32 v62, 22, v46
v_and_or_b32 v62, v62, s80, v3
v_cmp_gt_i32 s[66:67], 0, v47
v_lshrrev_b32 v63, 22, v47
v_and_or_b32 v63, v63, s80, v3
s_mov_b64 exec, s[52:53]
ds_add_rtn_u32 v48, v56, v2
s_mov_b64 exec, s[54:55]
ds_add_rtn_u32 v49, v57, v2
s_mov_b64 exec, s[56:57]
ds_add_rtn_u32 v50, v58, v2
s_mov_b64 exec, s[58:59]
ds_add_rtn_u32 v51, v59, v2
s_mov_b64 exec, s[60:61]
ds_add_rtn_u32 v52, v60, v2
s_mov_b64 exec, s[62:63]
ds_add_rtn_u32 v53, v61, v2
s_mov_b64 exec, s[64:65]
ds_add_rtn_u32 v54, v62, v2
s_mov_b64 exec, s[66:67]
ds_add_rtn_u32 v55, v63, v2
s_mov_b64 exec, -1
v_lshl_add_u32 v94, v1, 3, v3
s_or_b32 s76, s72, s68
s_cbranch_scc1 G_nooc
v_lshlrev_b32 v95, 4, v1
s_mov_b32 s76, 65536
buffer_load_dwordx4 v[104:107], v95, s[36:39], s76 offen sc1
G_nooc:
s_waitcnt lgkmcnt(0)
s_barrier
ds_read_b64 v[84:85], v94
v_and_b32 v97, 3, v1
v_cmp_eq_u32 vcc, 3, v97
s_waitcnt lgkmcnt(0)
v_add_u32 v86, v84, v85
s_nop 1
v_add_u32_dpp v87, v86, v86 quad_perm:[1,0,3,2] row_mask:0xf bank_mask:0xf
s_nop 1
v_add_u32_dpp v87, v87, v87 quad_perm:[2,3,0,1] row_mask:0xf bank_mask:0xf
v_sub_u32 v97, 0, v87
v_and_b32 v97, 31, v97
v_cndmask_b32 v97, 0, v97, vcc
v_add_u32 v95, v86, v97
v_mov_b32 v96, v95
s_nop 1
v_add_u32_dpp v96, v96, v96 row_shr:1 row_mask:0xf bank_mask:0xf bound_ctrl:0
s_nop 1
v_add_u32_dpp v96, v96, v96 row_shr:2 row_mask:0xf bank_mask:0xf bound_ctrl:0
s_nop 1
v_add_u32_dpp v96, v96, v96 row_shr:4 row_mask:0xf bank_mask:0xf bound_ctrl:0
s_nop 1
v_add_u32_dpp v96, v96, v96 row_shr:8 row_mask:0xf bank_mask:0xf bound_ctrl:0
s_nop 1
v_add_u32_dpp v96, v96, v96 row_bcast:15 row_mask:0xa bank_mask:0xf
s_nop 1
v_add_u32_dpp v96, v96, v96 row_bcast:31 row_mask:0xc bank_mask:0xf
s_lshl_b32 s77, s68, 2
v_sub_u32 v95, v96, v95
v_readlane_b32 s76, v96, 63
v_readlane_b32 s70, v87, s77
v_readlane_b32 s69, v95, s77
v_add_u32 v85, v95, v84
v_mov_b32 v97, 131072
v_lshl_add_u32 v84, v95, 2, v97
v_lshl_add_u32 v85, v85, 2, v97
s_cmp_gt_u32 s76, 5728
s_cbranch_scc1 G_split
ds_write_b64 v94, v[84:85] offset:512
s_add_u32 s76, s69, s70
s_add_u32 s71, s70, 31
s_lshr_b32 s71, s71, 5
s_lshl_b32 s77, s71, 5
s_sub_u32 s77, s77, s70
v_add_u32 v98, s76, v1
v_lshl_add_u32 v98, v98, 2, v97
v_mov_b32 v99, 120
v_cmp_gt_u32 vcc, s77, v1
s_and_saveexec_b64 s[84:85], vcc
ds_write_b32 v98, v99
s_mov_b64 exec, -1
s_waitcnt lgkmcnt(0)
ds_read_b32 v64, v56 offset:512
ds_read_b32 v65, v57 offset:512
ds_read_b32 v66, v58 offset:512
ds_read_b32 v67, v59 offset:512
ds_read_b32 v68, v60 offset:512
ds_read_b32 v69, v61 offset:512
ds_read_b32 v70, v62 offset:512
ds_read_b32 v71, v63 offset:512
s_lshl_b32 s76, s69, 2
s_add_u32 s76, s76, 131072
v_lshrrev_b32 v38, 3, v1
v_lshlrev_b32 v38, 4, v38
v_add_u32 v38, s76, v38
v_and_b32 v39, 7, v1
v_bfe_u32 v98, v1, 3, 1
v_lshl_add_u32 v39, v39, 2, v98
v_lshlrev_b32 v39, 2, v39
v_add_u32 v39, s76, v39
s_waitcnt lgkmcnt(7)
v_lshl_add_u32 v64, v48, 2, v64
s_waitcnt lgkmcnt(6)
v_lshl_add_u32 v65, v49, 2, v65
s_waitcnt lgkmcnt(5)
v_lshl_add_u32 v66, v50, 2, v66
s_waitcnt lgkmcnt(4)
v_lshl_add_u32 v67, v51, 2, v67
s_waitcnt lgkmcnt(3)
v_lshl_add_u32 v68, v52, 2, v68
s_waitcnt lgkmcnt(2)
v_lshl_add_u32 v69, v53, 2, v69
s_waitcnt lgkmcnt(1)
v_lshl_add_u32 v70, v54, 2, v70
s_waitcnt lgkmcnt(0)
v_lshl_add_u32 v71, v55, 2, v71
s_mov_b64 exec, s[52:53]
ds_write_b32 v64, v40
s_mov_b64 exec, s[54:55]
ds_write_b32 v65, v41
s_mov_b64 exec, s[56:57]
ds_write_b32 v66, v42
s_mov_b64 exec, s[58:59]
ds_write_b32 v67, v43
s_mov_b64 exec, s[60:61]
ds_write_b32 v68, v44
s_mov_b64 exec, s[62:63]
ds_write_b32 v69, v45
s_mov_b64 exec, s[64:65]
ds_write_b32 v70, v46
s_mov_b64 exec, s[66:67]
ds_write_b32 v71, v47
s_mov_b64 exec, -1
s_cmp_lg_u32 s68, 0
s_cbranch_scc1 G_nofl
s_cmp_eq_u32 s72, 3
s_cbranch_scc1 G_nofl
v_cmp_gt_u32 s[84:85], 60, v1
s_waitcnt vmcnt(0)
v_or_b32 v98, v104, v105
v_or3_b32 v98, v98, v106, v107
v_cmp_ne_u32 vcc, 0, v98
s_and_b64 vcc, vcc, s[84:85]
s_or_b32 vcc_lo, vcc_lo, vcc_hi
v_mov_b32 v98, 154108
v_mov_b32 v99, vcc_lo
ds_write_b32 v98, v99
G_nofl:
s_waitcnt lgkmcnt(0)
s_barrier
s_cmp_eq_u32 s71, 0
s_cbranch_scc1 G_next
s_setprio 3
ds_read_b128 v[88:91], v38
ds_read_b128 v[84:87], v38 offset:128
ds_read2_b32 v[92:93], v39 offset0:0 offset1:2
s_waitcnt lgkmcnt(2)
s_add_u32 m0, s78, 0
v_and_or_b32 v94, v88, s73, v36
buffer_load_dwordx4 v94, s[20:23], 0 offen  lds
s_add_u32 m0, m0, 1024
v_and_or_b32 v95, v89, s73, v36
buffer_load_dwordx4 v95, s[20:23], 0 offen  lds
s_add_u32 m0, m0, 1024
v_and_or_b32 v96, v90, s73, v36
buffer_load_dwordx4 v96, s[20:23], 0 offen  lds
s_add_u32 m0, m0, 1024
v_and_or_b32 v97, v91, s73, v36
buffer_load_dwordx4 v97, s[20:23], 0 offen  lds
s_cmp_lt_u32 s71, 2
s_waitcnt lgkmcnt(0)
s_cbranch_scc1 G_loop
s_add_u32 m0, s78, 4096
v_and_or_b32 v94, v84, s73, v36
buffer_load_dwordx4 v94, s[20:23], 0 offen  lds
s_add_u32 m0, m0, 1024
v_and_or_b32 v95, v85, s73, v36
buffer_load_dwordx4 v95, s[20:23], 0 offen  lds
s_add_u32 m0, m0, 1024
v_and_or_b32 v96, v86, s73, v36
buffer_load_dwordx4 v96, s[20:23], 0 offen  lds
s_add_u32 m0, m0, 1024
v_and_or_b32 v97, v87, s73, v36
buffer_load_dwordx4 v97, s[20:23], 0 offen  lds
G_loop:
s_cmp_lg_u32 s71, 5
s_cbranch_scc1 G_t0p0
s_setprio 2
G_t0p0:
s_cmp_lg_u32 s71, 3
s_cbranch_scc1 G_t0p1
s_setprio 1
G_t0p1:
s_cmp_lg_u32 s71, 1
s_cbranch_scc1 G_t0p2
s_setprio 0
G_t0p2:
v_and_or_b32 v98, v92, s74, v37
v_and_or_b32 v99, v93, s74, v37
ds_read_b64 v[72:73], v98
ds_read_b64 v[74:75], v99
ds_read_b128 v[88:91], v38 offset:256
ds_read2_b32 v[92:93], v39 offset0:32 offset1:34
s_cmp_lg_u32 s71, 1
s_waitcnt lgkmcnt(2)
v_mfma_f32_16x16x16_bf16 v[76:79], v[72:73], v[28:29], 0
v_mfma_f32_16x16x16_bf16 v[80:83], v[74:75], v[28:29], 0
s_waitcnt vmcnt(4)
s_cbranch_scc1 G_t0a
s_waitcnt vmcnt(0)
G_t0a:
ds_read_b128 v[40:43], v34 offset:0
ds_read_b128 v[44:47], v35 offset:0
ds_read_b128 v[48:51], v34 offset:2048
ds_read_b128 v[52:55], v35 offset:2048
ds_read_b64_tr_b16 v[56:57], v30 offset:0
ds_read_b64_tr_b16 v[58:59], v30 offset:2048
ds_read_b64_tr_b16 v[60:61], v31 offset:0
ds_read_b64_tr_b16 v[62:63], v31 offset:2048
ds_read_b64_tr_b16 v[64:65], v32 offset:0
ds_read_b64_tr_b16 v[66:67], v32 offset:2048
ds_read_b64_tr_b16 v[68:69], v33 offset:0
ds_read_b64_tr_b16 v[70:71], v33 offset:2048
s_waitcnt lgkmcnt(11)
v_mfma_f32_16x16x32_bf16 v[76:79], v[40:43], v[20:23], v[76:79]
s_waitcnt lgkmcnt(10)
v_mfma_f32_16x16x32_bf16 v[76:79], v[44:47], v[24:27], v[76:79]
s_waitcnt lgkmcnt(9)
v_mfma_f32_16x16x32_bf16 v[80:83], v[48:51], v[20:23], v[80:83]
s_waitcnt lgkmcnt(8)
v_mfma_f32_16x16x32_bf16 v[80:83], v[52:55], v[24:27], v[80:83]
s_cmp_lt_u32 s71, 3
s_waitcnt lgkmcnt(0)
s_cbranch_scc1 G_t0b
s_add_u32 m0, s78, 0
v_and_or_b32 v94, v88, s73, v36
buffer_load_dwordx4 v94, s[20:23], 0 offen  lds
s_add_u32 m0, m0, 1024
v_and_or_b32 v95, v89, s73, v36
buffer_load_dwordx4 v95, s[20:23], 0 offen  lds
s_add_u32 m0, m0, 1024
v_and_or_b32 v96, v90, s73, v36
buffer_load_dwordx4 v96, s[20:23], 0 offen  lds
s_add_u32 m0, m0, 1024
v_and_or_b32 v97, v91, s73, v36
buffer_load_dwordx4 v97, s[20:23], 0 offen  lds
G_t0b:
s_nop 5
v_mul_f32 v76, s75, v76
v_mul_f32 v77, s75, v77
v_mul_f32 v78, s75, v78
v_mul_f32 v79, s75, v79
v_mul_f32 v80, s75, v80
v_mul_f32 v81, s75, v81
v_mul_f32 v82, s75, v82
v_mul_f32 v83, s75, v83
v_exp_f32 v76, v76
v_exp_f32 v77, v77
v_exp_f32 v78, v78
v_exp_f32 v79, v79
v_exp_f32 v80, v80
v_exp_f32 v81, v81
v_exp_f32 v82, v82
v_exp_f32 v83, v83
v_add_f32 v76, 1.0, v76
v_add_f32 v77, 1.0, v77
v_add_f32 v78, 1.0, v78
v_add_f32 v79, 1.0, v79
v_add_f32 v80, 1.0, v80
v_add_f32 v81, 1.0, v81
v_add_f32 v82, 1.0, v82
v_add_f32 v83, 1.0, v83
v_rcp_f32 v76, v76
v_rcp_f32 v77, v77
v_rcp_f32 v78, v78
v_rcp_f32 v79, v79
v_rcp_f32 v80, v80
v_rcp_f32 v81, v81
v_rcp_f32 v82, v82
v_rcp_f32 v83, v83
s_nop 0
v_cvt_pk_bf16_f32 v84, v76, v77
v_cvt_pk_bf16_f32 v85, v78, v79
v_cvt_pk_bf16_f32 v86, v80, v81
v_cvt_pk_bf16_f32 v87, v82, v83
s_sub_u32 s71, s71, 1
s_cmp_eq_u32 s71, 0
v_mfma_f32_16x16x32_bf16 v[4:7], v[56:59], v[84:87], v[4:7]
v_mfma_f32_16x16x32_bf16 v[8:11], v[60:63], v[84:87], v[8:11]
v_mfma_f32_16x16x32_bf16 v[12:15], v[64:67], v[84:87], v[12:15]
v_mfma_f32_16x16x32_bf16 v[16:19], v[68:71], v[84:87], v[16:19]
s_cbranch_scc1 G_next
s_cmp_lg_u32 s71, 5
s_cbranch_scc1 G_t1p0
s_setprio 2
G_t1p0:
s_cmp_lg_u32 s71, 3
s_cbranch_scc1 G_t1p1
s_setprio 1
G_t1p1:
s_cmp_lg_u32 s71, 1
s_cbranch_scc1 G_t1p2
s_setprio 0
G_t1p2:
v_and_or_b32 v98, v92, s74, v37
v_and_or_b32 v99, v93, s74, v37
ds_read_b64 v[72:73], v98
ds_read_b64 v[74:75], v99
ds_read_b128 v[88:91], v38 offset:384
ds_read2_b32 v[92:93], v39 offset0:64 offset1:66
s_cmp_lg_u32 s71, 1
s_waitcnt lgkmcnt(2)
v_mfma_f32_16x16x16_bf16 v[76:79], v[72:73], v[28:29], 0
v_mfma_f32_16x16x16_bf16 v[80:83], v[74:75], v[28:29], 0
s_waitcnt vmcnt(4)
s_cbranch_scc1 G_t1a
s_waitcnt vmcnt(0)
G_t1a:
ds_read_b128 v[40:43], v34 offset:4096
ds_read_b128 v[44:47], v35 offset:4096
ds_read_b128 v[48:51], v34 offset:6144
ds_read_b128 v[52:55], v35 offset:6144
ds_read_b64_tr_b16 v[56:57], v30 offset:4096
ds_read_b64_tr_b16 v[58:59], v30 offset:6144
ds_read_b64_tr_b16 v[60:61], v31 offset:4096
ds_read_b64_tr_b16 v[62:63], v31 offset:6144
ds_read_b64_tr_b16 v[64:65], v32 offset:4096
ds_read_b64_tr_b16 v[66:67], v32 offset:6144
ds_read_b64_tr_b16 v[68:69], v33 offset:4096
ds_read_b64_tr_b16 v[70:71], v33 offset:6144
s_waitcnt lgkmcnt(11)
v_mfma_f32_16x16x32_bf16 v[76:79], v[40:43], v[20:23], v[76:79]
s_waitcnt lgkmcnt(10)
v_mfma_f32_16x16x32_bf16 v[76:79], v[44:47], v[24:27], v[76:79]
s_waitcnt lgkmcnt(9)
v_mfma_f32_16x16x32_bf16 v[80:83], v[48:51], v[20:23], v[80:83]
s_waitcnt lgkmcnt(8)
v_mfma_f32_16x16x32_bf16 v[80:83], v[52:55], v[24:27], v[80:83]
s_cmp_lt_u32 s71, 3
s_waitcnt lgkmcnt(0)
s_cbranch_scc1 G_t1b
s_add_u32 m0, s78, 4096
v_and_or_b32 v94, v88, s73, v36
buffer_load_dwordx4 v94, s[20:23], 0 offen  lds
s_add_u32 m0, m0, 1024
v_and_or_b32 v95, v89, s73, v36
buffer_load_dwordx4 v95, s[20:23], 0 offen  lds
s_add_u32 m0, m0, 1024
v_and_or_b32 v96, v90, s73, v36
buffer_load_dwordx4 v96, s[20:23], 0 offen  lds
s_add_u32 m0, m0, 1024
v_and_or_b32 v97, v91, s73, v36
buffer_load_dwordx4 v97, s[20:23], 0 offen  lds
G_t1b:
s_nop 5
v_mul_f32 v76, s75, v76
v_mul_f32 v77, s75, v77
v_mul_f32 v78, s75, v78
v_mul_f32 v79, s75, v79
v_mul_f32 v80, s75, v80
v_mul_f32 v81, s75, v81
v_mul_f32 v82, s75, v82
v_mul_f32 v83, s75, v83
v_exp_f32 v76, v76
v_exp_f32 v77, v77
v_exp_f32 v78, v78
v_exp_f32 v79, v79
v_exp_f32 v80, v80
v_exp_f32 v81, v81
v_exp_f32 v82, v82
v_exp_f32 v83, v83
v_add_f32 v76, 1.0, v76
v_add_f32 v77, 1.0, v77
v_add_f32 v78, 1.0, v78
v_add_f32 v79, 1.0, v79
v_add_f32 v80, 1.0, v80
v_add_f32 v81, 1.0, v81
v_add_f32 v82, 1.0, v82
v_add_f32 v83, 1.0, v83
v_rcp_f32 v76, v76
v_rcp_f32 v77, v77
v_rcp_f32 v78, v78
v_rcp_f32 v79, v79
v_rcp_f32 v80, v80
v_rcp_f32 v81, v81
v_rcp_f32 v82, v82
v_rcp_f32 v83, v83
v_add_u32 v38, 256, v38
v_add_u32 v39, 256, v39
v_cvt_pk_bf16_f32 v84, v76, v77
v_cvt_pk_bf16_f32 v85, v78, v79
v_cvt_pk_bf16_f32 v86, v80, v81
v_cvt_pk_bf16_f32 v87, v82, v83
s_sub_u32 s71, s71, 1
s_cmp_eq_u32 s71, 0
v_mfma_f32_16x16x32_bf16 v[4:7], v[56:59], v[84:87], v[4:7]
v_mfma_f32_16x16x32_bf16 v[8:11], v[60:63], v[84:87], v[8:11]
v_mfma_f32_16x16x32_bf16 v[12:15], v[64:67], v[84:87], v[12:15]
v_mfma_f32_16x16x32_bf16 v[16:19], v[68:71], v[84:87], v[16:19]
s_cbranch_scc0 G_loop
G_next:
s_cmp_eq_u32 s72, 1
s_cbranch_scc1 G_half2
s_cmp_eq_u32 s72, 3
s_cbranch_scc1 G_have
v_mov_b32 v98, 154108
ds_read_b32 v99, v98
s_waitcnt lgkmcnt(0)
v_cmp_ne_u32 vcc, 0, v99
s_cbranch_vccz G_epi
s_mov_b32 s72, 3
v_lshlrev_b32 v95, 4, v1
s_mov_b32 s76, 65536
buffer_load_dwordx4 v[104:107], v95, s[36:39], s76 offen sc1
v_cmp_gt_u32 s[84:85], 60, v1
s_waitcnt vmcnt(0)
v_cmp_ne_u32 s[44:45], 0, v104
v_cmp_ne_u32 s[46:47], 0, v105
v_cmp_ne_u32 s[48:49], 0, v106
v_cmp_ne_u32 s[50:51], 0, v107
s_and_b64 s[44:45], s[44:45], s[84:85]
s_and_b64 s[46:47], s[46:47], s[84:85]
s_and_b64 s[48:49], s[48:49], s[84:85]
s_and_b64 s[50:51], s[50:51], s[84:85]
G_have:
s_ff1_i32_b64 s82, s[44:45]
s_cmp_lg_i32 s82, -1
s_cbranch_scc1 G_f0
s_ff1_i32_b64 s82, s[46:47]
s_cmp_lg_i32 s82, -1
s_cbranch_scc1 G_f1
s_ff1_i32_b64 s82, s[48:49]
s_cmp_lg_i32 s82, -1
s_cbranch_scc1 G_f2
s_ff1_i32_b64 s82, s[50:51]
s_cmp_lg_i32 s82, -1
s_cbranch_scc1 G_f3
s_branch G_epi
G_f0:
s_bitset0_b64 s[44:45], s82
v_readlane_b32 s86, v104, s82
s_lshl_b32 s82, s82, 2
s_add_u32 s82, s82, 0
s_branch G_ovl
G_f1:
s_bitset0_b64 s[46:47], s82
v_readlane_b32 s86, v105, s82
s_lshl_b32 s82, s82, 2
s_add_u32 s82, s82, 1
s_branch G_ovl
G_f2:
s_bitset0_b64 s[48:49], s82
v_readlane_b32 s86, v106, s82
s_lshl_b32 s82, s82, 2
s_add_u32 s82, s82, 2
s_branch G_ovl
G_f3:
s_bitset0_b64 s[50:51], s82
v_readlane_b32 s86, v107, s82
s_lshl_b32 s82, s82, 2
s_add_u32 s82, s82, 3
s_branch G_ovl
G_ovl:
s_mul_i32 s76, s82, 13344
v_lshlrev_b32 v94, 4, v0
buffer_load_dwordx4 v[48:51], v94, s[40:43], s76 offen sc1
v_lshlrev_b32 v94, 2, v0
s_waitcnt vmcnt(0)
v_lshrrev_b32 v95, 16, v48
v_and_b32 v96, 0xffff, v48
v_mul_u32_u24 v97, 40330, v95
v_lshrrev_b32 v97, 19, v97
v_mad_i32_i24 v98, v97, -13, v95
v_lshl_or_b32 v40, v96, 7, s79
v_lshl_or_b32 v40, v98, 3, v40
v_lshrrev_b32 v98, 13, v96
v_and_b32 v99, 15, v97
v_lshl_or_b32 v98, v99, 3, v98
v_lshl_or_b32 v40, v98, 24, v40
v_lshrrev_b32 v97, 4, v97
v_cmp_eq_u32 vcc, s2, v97
v_add_u32 v98, 0, v94
v_cmp_gt_u32 s[84:85], s86, v98
s_and_b64 vcc, vcc, s[84:85]
s_nop 1
v_cndmask_b32 v40, 0, v40, vcc
v_lshrrev_b32 v95, 16, v49
v_and_b32 v96, 0xffff, v49
v_mul_u32_u24 v97, 40330, v95
v_lshrrev_b32 v97, 19, v97
v_mad_i32_i24 v98, v97, -13, v95
v_lshl_or_b32 v41, v96, 7, s79
v_lshl_or_b32 v41, v98, 3, v41
v_lshrrev_b32 v98, 13, v96
v_and_b32 v99, 15, v97
v_lshl_or_b32 v98, v99, 3, v98
v_lshl_or_b32 v41, v98, 24, v41
v_lshrrev_b32 v97, 4, v97
v_cmp_eq_u32 vcc, s2, v97
v_add_u32 v98, 1, v94
v_cmp_gt_u32 s[84:85], s86, v98
s_and_b64 vcc, vcc, s[84:85]
s_nop 1
v_cndmask_b32 v41, 0, v41, vcc
v_lshrrev_b32 v95, 16, v50
v_and_b32 v96, 0xffff, v50
v_mul_u32_u24 v97, 40330, v95
v_lshrrev_b32 v97, 19, v97
v_mad_i32_i24 v98, v97, -13, v95
v_lshl_or_b32 v42, v96, 7, s79
v_lshl_or_b32 v42, v98, 3, v42
v_lshrrev_b32 v98, 13, v96
v_and_b32 v99, 15, v97
v_lshl_or_b32 v98, v99, 3, v98
v_lshl_or_b32 v42, v98, 24, v42
v_lshrrev_b32 v97, 4, v97
v_cmp_eq_u32 vcc, s2, v97
v_add_u32 v98, 2, v94
v_cmp_gt_u32 s[84:85], s86, v98
s_and_b64 vcc, vcc, s[84:85]
s_nop 1
v_cndmask_b32 v42, 0, v42, vcc
v_lshrrev_b32 v95, 16, v51
v_and_b32 v96, 0xffff, v51
v_mul_u32_u24 v97, 40330, v95
v_lshrrev_b32 v97, 19, v97
v_mad_i32_i24 v98, v97, -13, v95
v_lshl_or_b32 v43, v96, 7, s79
v_lshl_or_b32 v43, v98, 3, v43
v_lshrrev_b32 v98, 13, v96
v_and_b32 v99, 15, v97
v_lshl_or_b32 v98, v99, 3, v98
v_lshl_or_b32 v43, v98, 24, v43
v_lshrrev_b32 v97, 4, v97
v_cmp_eq_u32 vcc, s2, v97
v_add_u32 v98, 3, v94
v_cmp_gt_u32 s[84:85], s86, v98
s_and_b64 vcc, vcc, s[84:85]
s_nop 1
v_cndmask_b32 v43, 0, v43, vcc
v_mov_b32 v44, 0
v_mov_b32 v45, 0
v_mov_b32 v46, 0
v_mov_b32 v47, 0
s_branch G_again
G_half2:
v_mov_b32 v40, v100
v_mov_b32 v44, 0
v_mov_b32 v41, v101
v_mov_b32 v45, 0
v_mov_b32 v42, v102
v_mov_b32 v46, 0
v_mov_b32 v43, v103
v_mov_b32 v47, 0
s_mov_b32 s72, 2
s_branch G_again
G_split:
v_mov_b32 v100, v44
v_mov_b32 v44, 0
v_mov_b32 v101, v45
v_mov_b32 v45, 0
v_mov_b32 v102, v46
v_mov_b32 v46, 0
v_mov_b32 v103, v47
v_mov_b32 v47, 0
s_mov_b32 s72, 1
G_again:
s_waitcnt lgkmcnt(0)
s_barrier
v_mov_b32 v84, 0
v_mov_b32 v85, 0
v_lshl_add_u32 v94, v1, 3, v3
ds_write_b64 v94, v[84:85]
s_waitcnt lgkmcnt(0)
s_barrier
s_branch G_batch
G_epi:
v_lshrrev_b32 v88, 2, v1
v_lshlrev_b32 v88, 7, v88
v_and_b32 v89, 3, v1
v_lshl_add_u32 v88, v89, 5, v88
v_add_u32 v88, 155648, v88
ds_read_b64_tr_b16 v[40:41], v88 offset:0
ds_read_b64_tr_b16 v[42:43], v88 offset:2048
ds_read_b64_tr_b16 v[44:45], v88 offset:4096
ds_read_b64_tr_b16 v[46:47], v88 offset:6144
ds_read_b64_tr_b16 v[48:49], v88 offset:8
ds_read_b64_tr_b16 v[50:51], v88 offset:2056
ds_read_b64_tr_b16 v[52:53], v88 offset:4104
ds_read_b64_tr_b16 v[54:55], v88 offset:6152
ds_read_b64_tr_b16 v[56:57], v88 offset:16
ds_read_b64_tr_b16 v[58:59], v88 offset:2064
ds_read_b64_tr_b16 v[60:61], v88 offset:4112
ds_read_b64_tr_b16 v[62:63], v88 offset:6160
ds_read_b64_tr_b16 v[64:65], v88 offset:24
ds_read_b64_tr_b16 v[66:67], v88 offset:2072
ds_read_b64_tr_b16 v[68:69], v88 offset:4120
ds_read_b64_tr_b16 v[70:71], v88 offset:6168
v_cvt_pk_bf16_f32 v72, v4, v5
v_lshlrev_b32 v20, 16, v72
v_and_b32 v21, 0xffff0000, v72
v_sub_f32 v20, v4, v20
v_sub_f32 v21, v5, v21
v_cvt_pk_bf16_f32 v80, v20, v21
v_cvt_pk_bf16_f32 v73, v6, v7
v_lshlrev_b32 v20, 16, v73
v_and_b32 v21, 0xffff0000, v73
v_sub_f32 v20, v6, v20
v_sub_f32 v21, v7, v21
v_cvt_pk_bf16_f32 v81, v20, v21
v_cvt_pk_bf16_f32 v74, v8, v9
v_lshlrev_b32 v20, 16, v74
v_and_b32 v21, 0xffff0000, v74
v_sub_f32 v20, v8, v20
v_sub_f32 v21, v9, v21
v_cvt_pk_bf16_f32 v82, v20, v21
v_cvt_pk_bf16_f32 v75, v10, v11
v_lshlrev_b32 v20, 16, v75
v_and_b32 v21, 0xffff0000, v75
v_sub_f32 v20, v10, v20
v_sub_f32 v21, v11, v21
v_cvt_pk_bf16_f32 v83, v20, v21
v_cvt_pk_bf16_f32 v76, v12, v13
v_lshlrev_b32 v20, 16, v76
v_and_b32 v21, 0xffff0000, v76
v_sub_f32 v20, v12, v20
v_sub_f32 v21, v13, v21
v_cvt_pk_bf16_f32 v84, v20, v21
v_cvt_pk_bf16_f32 v77, v14, v15
v_lshlrev_b32 v20, 16, v77
v_and_b32 v21, 0xffff0000, v77
v_sub_f32 v20, v14, v20
v_sub_f32 v21, v15, v21
v_cvt_pk_bf16_f32 v85, v20, v21
v_cvt_pk_bf16_f32 v78, v16, v17
v_lshlrev_b32 v20, 16, v78
v_and_b32 v21, 0xffff0000, v78
v_sub_f32 v20, v16, v20
v_sub_f32 v21, v17, v21
v_cvt_pk_bf16_f32 v86, v20, v21
v_cvt_pk_bf16_f32 v79, v18, v19
v_lshlrev_b32 v20, 16, v79
v_and_b32 v21, 0xffff0000, v79
v_sub_f32 v20, v18, v20
v_sub_f32 v21, v19, v21
v_cvt_pk_bf16_f32 v87, v20, v21
v_and_b32 v22, 15, v1
v_lshrrev_b32 v23, 4, v1
v_lshlrev_b32 v24, 7, v22
v_lshl_add_u32 v24, v23, 5, v24
v_cmp_gt_u32 vcc, 13, v22
s_waitcnt lgkmcnt(0)
v_mfma_f32_16x16x32_bf16 v[88:91], v[40:43], v[80:83], 0
v_mfma_f32_16x16x32_bf16 v[92:95], v[48:51], v[80:83], 0
v_mfma_f32_16x16x32_bf16 v[96:99], v[56:59], v[80:83], 0
v_mfma_f32_16x16x32_bf16 v[100:103], v[64:67], v[80:83], 0
v_mfma_f32_16x16x32_bf16 v[88:91], v[44:47], v[84:87], v[88:91]
v_mfma_f32_16x16x32_bf16 v[92:95], v[52:55], v[84:87], v[92:95]
v_mfma_f32_16x16x32_bf16 v[96:99], v[60:63], v[84:87], v[96:99]
v_mfma_f32_16x16x32_bf16 v[100:103], v[68:71], v[84:87], v[100:103]
v_mfma_f32_16x16x32_bf16 v[88:91], v[40:43], v[72:75], v[88:91]
v_mfma_f32_16x16x32_bf16 v[92:95], v[48:51], v[72:75], v[92:95]
v_mfma_f32_16x16x32_bf16 v[96:99], v[56:59], v[72:75], v[96:99]
v_mfma_f32_16x16x32_bf16 v[100:103], v[64:67], v[72:75], v[100:103]
v_mfma_f32_16x16x32_bf16 v[88:91], v[44:47], v[76:79], v[88:91]
v_mfma_f32_16x16x32_bf16 v[92:95], v[52:55], v[76:79], v[92:95]
v_mfma_f32_16x16x32_bf16 v[96:99], v[60:63], v[76:79], v[96:99]
v_mfma_f32_16x16x32_bf16 v[100:103], v[68:71], v[76:79], v[100:103]
s_nop 7
v_cvt_pk_bf16_f32 v4, v88, v89
v_cvt_pk_bf16_f32 v5, v90, v91
v_cvt_pk_bf16_f32 v6, v92, v93
v_cvt_pk_bf16_f32 v7, v94, v95
v_cvt_pk_bf16_f32 v8, v96, v97
v_cvt_pk_bf16_f32 v9, v98, v99
v_cvt_pk_bf16_f32 v10, v100, v101
v_cvt_pk_bf16_f32 v11, v102, v103
s_and_saveexec_b64 s[84:85], vcc
buffer_store_dwordx4 v[4:7], v24, s[32:35], s81 offen nt
buffer_store_dwordx4 v[8:11], v24, s[32:35], s81 offen offset:16 nt
G_end:
s_endpgm
.section .rodata,"a"
.p2align 6
.amdhsa_kernel gather_scatter__kernel_systems_refs_featgraph__graph_kernel
  .amdhsa_next_free_vgpr 112
  .amdhsa_next_free_sgpr 100
  .amdhsa_accum_offset 112
  .amdhsa_group_segment_fixed_size 0
  .amdhsa_kernarg_size 64
  .amdhsa_user_sgpr_count 2
  .amdhsa_user_sgpr_kernarg_segment_ptr 1
  .amdhsa_system_sgpr_workgroup_id_x 1
.end_amdhsa_kernel
```
